```python
import torch

def _softmax(x, axis=-1):
    return torch.softmax(x, dim=axis)
def _gelu(x):
    return torch.nn.functional.gelu(x, approximate="tanh")
def _silu(x):
    return torch.nn.functional.silu(x)
def _sigmoid(x):
    return torch.sigmoid(x)
def _layernorm(x, axis=-1, eps=1e-5):
    m = x.mean(dim=axis, keepdim=True)
    v = x.var(dim=axis, keepdim=True, unbiased=False)
    return (x - m) / torch.sqrt(v + eps)
def _scatter_add(tgt, idx, src, axis=0):
    return tgt.clone().index_add_(axis, idx, src)
def _segment_sum(src, seg, n):
    out = torch.zeros((n,) + src.shape[1:], dtype=src.dtype)
    return out.index_add_(0, seg, src)
def _pad(x, pw):
    flat = tuple(v for pair in reversed(pw) for v in pair)
    return torch.nn.functional.pad(x, flat)

kernel_name = 'concat_heads__sliding_block_cached__sliding_block_cached__decode'

def setup_inputs():

    _w = (lambda a: (lambda t: t.to(torch.bfloat16) if t.is_floating_point() else t)(torch.as_tensor(a)))
    def _A_setup():
        B, Sq, D = 2, 1, 1024
        Hq, Hkv, Sk, Dh = 32, 4, 32768, 128
        assert Hq % Hkv == 0, (Hq, Hkv)
        return {
            "x": _w((lambda *s: torch.randn(*s, dtype=torch.bfloat16) * 0.8)(B, Sq, D)),
            "k_cache": _w((lambda *s: torch.randn(*s, dtype=torch.bfloat16) * 0.8)(B, Hkv, Sk, Dh)),
            "v_cache": _w((lambda *s: torch.randn(*s, dtype=torch.bfloat16) * 0.05)(B, Hkv, Sk, Dh)),
            "wq": _w((lambda *s: torch.randn(*s, dtype=torch.bfloat16) * 0.8)(D, Hq * Dh) * (D ** -0.5)),
            "wo": _w((lambda *s: torch.randn(*s, dtype=torch.bfloat16) * 0.05)(Hq * Dh, D) * ((Hq * Dh) ** -0.5)),
        }
    _A_in = _A_setup()

    def _B_setup():
        B, Sq, D = 2, 1, 1024
        Hq, Hkv, Sk, Dh = 32, 4, 32768, 128
        assert Hq % Hkv == 0, (Hq, Hkv)
        return {
            "x": _w((lambda *s: torch.randn(*s, dtype=torch.bfloat16) * 0.8)(B, Sq, D)),
            "k_cache": _w((lambda *s: torch.randn(*s, dtype=torch.bfloat16) * 0.8)(B, Hkv, Sk, Dh)),
            "v_cache": _w((lambda *s: torch.randn(*s, dtype=torch.bfloat16) * 0.05)(B, Hkv, Sk, Dh)),
            "wq": _w((lambda *s: torch.randn(*s, dtype=torch.bfloat16) * 0.8)(D, Hq * Dh) * (D ** -0.5)),
            "wo": _w((lambda *s: torch.randn(*s, dtype=torch.bfloat16) * 0.05)(Hq * Dh, D) * ((Hq * Dh) ** -0.5)),
        }
    _B_in = _B_setup()

    return {
        "A_x": _A_in["x"],
        "A_k_cache": _A_in["k_cache"],
        "A_v_cache": _A_in["v_cache"],
        "A_wq": _A_in["wq"],
        "A_wo": _A_in["wo"],
        "B_x": _B_in["x"],
        "B_k_cache": _B_in["k_cache"],
        "B_v_cache": _B_in["v_cache"],
        "B_wq": _B_in["wq"],
        "B_wo": _B_in["wo"],
    }

def reference(A_x, A_k_cache, A_v_cache, A_wq, A_wo, B_x, B_k_cache, B_v_cache, B_wq, B_wo):
    def _A_ref(x, k_cache, v_cache, wq, wo):
        B, Sq, D = x.shape
        Hq, Dh = 32, 128
        Hkv, Sk = k_cache.shape[1], k_cache.shape[2]
        W = min(4096, max(256, Sk // 4))
        rep = Hq // Hkv
        q = (lambda x, *d: x.permute(*d))((x @ wq).reshape(B, Sq, Hq, Dh), 0, 2, 1, 3)
        k = (lambda x, n, axis: torch.repeat_interleave(x, n, dim=axis))(k_cache[:, :, Sk - W:, :], rep, axis=1)
        v = (lambda x, n, axis: torch.repeat_interleave(x, n, dim=axis))(v_cache[:, :, Sk - W:, :], rep, axis=1)
        scores = torch.einsum("bhqd,bhkd->bhqk", q, k) * (Dh ** -0.5)
        p = _softmax(scores, axis=-1)
        o = torch.einsum("bhqk,bhkd->bhqd", p, v)
        return (lambda x, *d: x.permute(*d))(o, 0, 2, 1, 3).reshape(B, Sq, Hq * Dh) @ wo

    def _B_ref(x, k_cache, v_cache, wq, wo):
        B, Sq, D = x.shape
        Hq, Dh = 32, 128
        Hkv, Sk = k_cache.shape[1], k_cache.shape[2]
        W = min(4096, max(256, Sk // 4))
        rep = Hq // Hkv
        q = (lambda x, *d: x.permute(*d))((x @ wq).reshape(B, Sq, Hq, Dh), 0, 2, 1, 3)
        k = (lambda x, n, axis: torch.repeat_interleave(x, n, dim=axis))(k_cache[:, :, Sk - W:, :], rep, axis=1)
        v = (lambda x, n, axis: torch.repeat_interleave(x, n, dim=axis))(v_cache[:, :, Sk - W:, :], rep, axis=1)
        scores = torch.einsum("bhqd,bhkd->bhqk", q, k) * (Dh ** -0.5)
        p = _softmax(scores, axis=-1)
        o = torch.einsum("bhqk,bhkd->bhqd", p, v)
        return (lambda x, *d: x.permute(*d))(o, 0, 2, 1, 3).reshape(B, Sq, Hq * Dh) @ wo

    a = _A_ref(A_x, A_k_cache, A_v_cache, A_wq, A_wo)
    b = _B_ref(B_x, B_k_cache, B_v_cache, B_wq, B_wo)
    return torch.concatenate([a, b], axis=-1)
```

```asm
; @launch grid=(256,1,1) block=(576,1,1) lds=151552
    .amdgcn_target "amdgcn-amd-amdhsa--gfx950"
    .text
    .globl concat_heads__sliding_block_cached__sliding_block_cached__decode_kernel
    .p2align 8
    .type concat_heads__sliding_block_cached__sliding_block_cached__decode_kernel,@function
concat_heads__sliding_block_cached__sliding_block_cached__decode_kernel:
    s_bfe_u32 s34, s2, 0x10002
    s_mul_i32 s36, s34, 40
    s_load_dwordx2 s[16:17], s[0:1], s36 offset:24
    s_load_dwordx2 s[20:21], s[0:1], s36 offset:8
    v_readfirstlane_b32 s44, v0
    s_cmpk_ge_u32 s2, 256
    s_cbranch_scc1 L_end
    s_and_b32 s35, s2, 3
    s_lshr_b32 s48, s2, 7
    s_cmp_ge_u32 s44, 64
    s_cbranch_scc1 L_cons
    v_lshrrev_b32 v6, 4, v0
    v_lshlrev_b32 v7, 1, v6
    v_xor_b32 v7, v7, v0
    v_and_b32 v7, 7, v7
    v_lshlrev_b32 v2, 13, v6
    v_lshl_add_u32 v2, v7, 4, v2
    s_lshr_b32 s46, s2, 3
    s_lshl2_add_u32 s45, s46, s35
    s_cmp_eq_u32 s35, 1
    s_cselect_b32 s49, 4, 12
    s_cselect_b32 s50, 21, 7
    s_cselect_b32 s47, 15, 16
    s_mul_i32 s45, s45, 0x20100
    v_and_b32 v7, 8, v0
    v_lshl_or_b32 v2, v7, s49, v2
    s_lshl_b32 s49, 8, s49
    s_and_b32 s45, s45, 0x401f00
    v_xor_b32 v3, s49, v2
    s_lshl_b32 s50, s48, s50
    s_or_b32 s45, s45, s50
    s_lshl_b32 s18, 1, 23
    s_mov_b32 s19, 0x20000
    s_mov_b32 m0, 0
    s_lshl_b32 s47, 1, s47
    s_waitcnt lgkmcnt(0)
L_burst:
    s_waitcnt vmcnt(22)
    buffer_load_dwordx4 v2, s[16:19], s45 offen nt lds
    s_addk_i32 m0, 1024
    s_add_u32 s45, s45, s47
    buffer_load_dwordx4 v3, s[16:19], s45 offen nt lds
    s_addk_i32 m0, 1024
    s_add_u32 s45, s45, s47
    s_cmpk_lg_u32 m0, 36864
    s_cbranch_scc1 L_nb
    s_barrier
L_nb:
    s_cmpk_lt_u32 m0, 0xffff
    s_cbranch_scc1 L_burst
    s_and_b32 s46, s46, 15
    v_lshlrev_b32 v1, 4, v0
    v_and_b32 v18, 0x30, v0
    v_lshlrev_b32 v18, 1, v18
    v_xor_b32 v18, v18, v1
    s_branch L_isk0_0
L_isl0_0:
    s_branch L_isl0_8
L_isk0_0:
    v_xor_b32 v19, 0x80, v18
    s_lshl_b32 s22, 1, 26
    s_mov_b32 s23, 0x20000
    s_lshl_b32 s49, s48, 25
    s_lshl_b32 s47, s35, 23
    s_add_u32 s49, s49, s47
    s_lshl_b32 s47, s46, 16
    s_add_u32 s49, s49, s47
    s_add_u32 s55, s49, 7340032
    s_lshl_b32 s47, s2, 1
    s_add_u32 s47, s47, s48
    s_branch L_isk0_1
L_isl0_1:
    s_branch L_isl0_9
L_isk0_1:
    s_add_u32 s47, s47, s46
    s_and_b32 s47, s47, 15
    s_lshl_b32 s47, s47, 12
    s_or_b32 s49, s55, s47
    s_mov_b32 s50, s49
    v_mov_b32 v23, 40
    v_mov_b32 v24, 131072
    s_load_dwordx2 s[24:25], s[0:1], s36 offset:16
    s_load_dwordx2 s[28:29], s[0:1], s36 offset:32
    s_setprio 3
    s_mov_b32 s52, 15
L_ld_k:
    s_branch L_isk0_2
L_isl0_2:
    s_branch L_isl0_10
L_isk0_2:
    s_waitcnt vmcnt(20)
    buffer_load_dwordx4 v18, s[20:23], s49 offen offset:0 nt lds
    buffer_load_dwordx4 v19, s[20:23], s49 offen offset:1024 nt lds
    buffer_load_dwordx4 v18, s[20:23], s49 offen offset:2048 nt lds
    buffer_load_dwordx4 v19, s[20:23], s49 offen offset:3072 nt lds
    s_addk_i32 m0, 4096
    s_add_u32 s49, s49, 4096
    s_and_b32 s49, s49, 0xffff
    s_branch L_isk0_3
L_isl0_3:
    s_branch L_isl0_11
L_isk0_3:
    s_or_b32 s49, s49, s55
    v_add_u32 v23, 4, v23
    ds_write_b32 v24, v23
    s_sub_u32 s52, s52, 1
    s_cbranch_scc0 L_ld_k
L_ld_j1:
    s_lshl_b32 s26, 1, 26
    s_mov_b32 s27, 0x20000
    s_mov_b32 m0, 0
    s_mov_b32 s53, 0x2000000
L_fr_1:
    ds_read_b32 v26, v24 offset:4
    s_branch L_isk0_4
L_isl0_4:
    s_branch L_islb0
L_isk0_4:
    s_sub_u32 s53, s53, 1
    s_cbranch_scc1 L_end
    s_waitcnt lgkmcnt(0)
    v_readfirstlane_b32 s54, v26
    s_cmp_lt_u32 s54, 8
    s_cbranch_scc1 L_fr_1
    s_waitcnt lgkmcnt(0)
    s_mov_b32 s52, 15
L_ld_v:
    s_waitcnt vmcnt(20)
    buffer_load_dwordx4 v18, s[24:27], s50 offen offset:0 nt lds
    buffer_load_dwordx4 v19, s[24:27], s50 offen offset:1024 nt lds
    buffer_load_dwordx4 v18, s[24:27], s50 offen offset:2048 nt lds
    s_branch L_isk0_5
L_isl0_5:
    s_branch L_islb0
L_isk0_5:
    buffer_load_dwordx4 v19, s[24:27], s50 offen offset:3072 nt lds
    s_addk_i32 m0, 4096
    s_add_u32 s50, s50, 4096
    s_and_b32 s50, s50, 0xffff
    s_or_b32 s50, s50, s55
    v_add_u32 v23, 4, v23
    ds_write_b32 v24, v23
    s_sub_u32 s52, s52, 1
    s_cbranch_scc0 L_ld_v
L_ld_j2:
    s_branch L_isk0_6
L_isl0_6:
    s_branch L_islb0
L_isk0_6:
    v_lshrrev_b32 v8, 5, v0
    v_and_b32 v9, 0x1f0, v1
    v_lshlrev_b32 v14, 5, v8
    v_xor_b32 v9, v9, v14
    v_lshl_add_u32 v10, v8, 11, v9
    v_xor_b32 v11, 64, v10
    v_add_u32 v11, 3072, v11
    v_xor_b32 v12, 128, v10
    v_add_u32 v12, 6144, v12
    s_branch L_isk0_7
L_isl0_7:
    s_branch L_islb0
L_isk0_7:
    v_xor_b32 v13, 192, v10
    v_add_u32 v13, 9216, v13
    s_lshl_b32 s30, 1, 23
    s_mov_b32 s31, 0x20000
    s_lshr_b32 s51, s2, 3
    s_lshl_b32 s54, s34, 3
    s_add_u32 s54, s54, s51
    s_and_b32 s54, s54, 15
    s_lshl_b32 s55, s51, 18
    s_lshl_b32 s54, s54, 14
    s_lshl_b32 s47, s35, 9
    s_branch L_isk0_8
L_isl0_8:
    s_branch L_islb0
L_isk0_8:
    s_or_b32 s51, s54, s47
    s_or_b32 s51, s51, s55
    s_mov_b32 s53, 0x2000000
L_fr_2:
    ds_read_b32 v26, v24 offset:8
    s_sub_u32 s53, s53, 1
    s_cbranch_scc1 L_end
    s_waitcnt lgkmcnt(0)
    v_readfirstlane_b32 s54, v26
    s_cmp_lt_u32 s54, 8
    s_cbranch_scc1 L_fr_2
    s_waitcnt vmcnt(20)
    v_add_u32 v23, 4, v23
    s_branch L_isk0_9
L_isl0_9:
    s_branch L_islb0
L_isk0_9:
    ds_write_b32 v24, v23
    s_mov_b32 s52, 15
L_ld_wo:
    v_add_u32 v23, 4, v23
    s_waitcnt vmcnt(16)
    ds_write_b32 v24, v23
    buffer_load_dwordx4 v10, s[28:31], s51 offen offset:0 nt lds
    buffer_load_dwordx4 v11, s[28:31], s51 offen offset:1024 nt lds
    buffer_load_dwordx4 v12, s[28:31], s51 offen offset:2048 nt lds
    buffer_load_dwordx4 v13, s[28:31], s51 offen offset:3072 nt lds
    s_branch L_isk0_10
L_isl0_10:
    s_branch L_islb0
L_isk0_10:
    s_addk_i32 m0, 4096
    s_add_u32 s51, s51, 16384
    s_and_b32 s51, s51, 0x3ffff
    s_or_b32 s51, s51, s55
    s_sub_u32 s52, s52, 1
    s_cbranch_scc0 L_ld_wo
    s_waitcnt vmcnt(16)
    v_add_u32 v23, 4, v23
    ds_write_b32 v24, v23
    s_waitcnt vmcnt(12)
    s_branch L_isk0_11
L_isl0_11:
    s_branch L_islb0
L_isk0_11:
    v_add_u32 v23, 4, v23
    ds_write_b32 v24, v23
    s_waitcnt vmcnt(8)
    v_add_u32 v23, 4, v23
    ds_write_b32 v24, v23
    s_waitcnt vmcnt(0)
    s_barrier
    s_endpgm
L_snap:
    s_lshl_b32 s47, s37, 11
    s_add_u32 s47, s47, 1048576
    v_add_u32 v22, s47, v21
    s_lshl_b32 s47, s3, 16
    s_lshl_b32 s49, s33, 6
    s_add_u32 s47, s47, s49
    s_add_u32 s47, s47, 1048576
    v_lshrrev_b32 v20, 2, v0
    v_lshlrev_b32 v20, 11, v20
    v_and_b32 v23, 48, v21
    v_add3_u32 v20, v20, v23, s47
    s_mov_b32 m0, 139264
    v_add_u32 v23, 31744, v20
    global_load_lds_dwordx4 v22, s[12:13] sc1
    global_load_lds_dwordx4 v22, s[12:13] offset:1024 sc1
    s_mov_b32 m0, 141312
    s_nop 0
    global_load_lds_dwordx4 v20, s[12:13] sc1
    global_load_lds_dwordx4 v23, s[12:13] offset:1024 sc1
    s_branch L_snap_done
    .p2align 6
L_cons:
    s_load_dwordx2 s[12:13], s[0:1], 96
    s_load_dwordx2 s[14:15], s[0:1], s36
    s_load_dwordx2 s[40:41], s[0:1], 80
    s_lshr_b32 s44, s44, 6
    s_sub_u32 s44, s44, 1
    v_and_b32 v0, 63, v0
    s_lshr_b32 s33, s2, 3
    s_lshl_b32 s45, s34, 8
    s_and_b32 s3, s2, 7
    v_lshrrev_b32 v2, 4, v0
    v_lshlrev_b32 v21, 4, v0
    v_mov_b32 v17, 131072
    v_mov_b32 v18, 0
    v_lshl_add_u32 v19, v0, 2, v17
    ds_write_b32 v19, v18
    v_and_b32 v5, 1, v0
    v_lshlrev_b32 v5, 11, v5
    s_bfe_u32 s46, s2, 0x10006
    s_and_b32 s52, s33, 7
    s_lshl2_add_u32 s52, s52, s35
    s_bitcmp1_b32 0x22222222, s52
    s_cselect_b32 s4, 1, 0
    s_cselect_b32 s47, s48, 0
    s_cselect_b32 s49, 0, 8
    s_cselect_b32 s50, 3, 4
    v_and_or_b32 v5, v0, s49, v5
    s_lshl3_add_u32 s49, s44, 0
    v_add_u32 v6, s49, v2
    v_lshl_add_u32 v5, v6, s50, v5
    s_lshl1_add_u32 s47, s46, s47
    s_lshl_b32 s47, s47, 9
    v_add_u32 v5, s47, v5
    s_lshl_b32 s49, 4, s50
    v_add_u32 v6, s49, v5
    s_waitcnt lgkmcnt(0)
    s_load_dwordx2 s[42:43], s[12:13], s45
    global_load_dwordx2 v[64:65], v5, s[14:15]
    global_load_dwordx2 v[66:67], v6, s[14:15]
    s_barrier
    s_lshl_b32 s37, s3, 5
    s_add_u32 s37, s37, s33
    s_cmp_eq_u32 s44, 4
    s_waitcnt vmcnt(0)
    s_cbranch_scc1 L_snap
L_snap_done:
    s_cmp_eq_u32 s44, 0
    s_cbranch_scc1 L_isl0_0
    s_cmp_eq_u32 s44, 1
    s_cbranch_scc1 L_isl0_1
    s_cmp_eq_u32 s44, 2
    s_cbranch_scc1 L_isl0_2
    s_cmp_eq_u32 s44, 3
    s_cbranch_scc1 L_isl0_3
    s_cmp_eq_u32 s44, 4
    s_cbranch_scc1 L_isl0_4
    s_cmp_eq_u32 s44, 5
    s_cbranch_scc1 L_isl0_5
    s_cmp_eq_u32 s44, 6
    s_cbranch_scc1 L_isl0_6
    s_cmp_eq_u32 s44, 7
    s_cbranch_scc1 L_isl0_7
L_islb0:
    v_mov_b32 v18, 1
    v_and_b32 v1, 15, v0
    v_bfe_u32 v3, v0, 2, 2
    v_and_b32 v4, 3, v0
    s_lshl_b32 s50, s34, 5
    s_add_u32 s47, s52, s50
    s_lshl_b32 s47, s47, 4
    s_lshl2_add_u32 s49, s46, s48
    s_lshl1_add_u32 s50, s48, s46
    s_cmp_lg_u32 s4, 0
    s_cselect_b32 s49, s49, s50
    s_cselect_b32 s50, 16, 0
    s_add_u32 s47, s47, s49
    s_lshl_b32 s47, s47, 8
    s_add_u32 s47, s47, 65536
    v_lshrrev_b32 v22, 5, v0
    v_lshlrev_b32 v19, 11, v22
    v_and_b32 v20, s50, v0
    v_lshl_add_u32 v19, v20, 5, v19
    v_lshl_add_u32 v19, v1, 4, v19
    v_add_u32 v19, s47, v19
    s_mov_b32 s20, 0x30003
    s_mov_b32 s21, 0x30003
    v_lshl_add_u32 v7, v2, 2, v3
    v_and_b32 v6, 7, v7
    v_and_b32 v5, 7, v0
    s_lshl_b32 s47, s44, 13
    v_lshlrev_b32 v8, 8, v7
    v_lshl_add_u32 v8, v4, 3, v8
    v_lshl_add_u32 v8, v6, 5, v8
    v_add_u32 v8, s47, v8
    v_and_b32 v20, 1, v0
    v_lshlrev_b32 v20, 9, v20
    v_bfe_u32 v22, v0, 1, 3
    v_lshl_add_u32 v20, v22, 6, v20
    v_lshl_add_u32 v20, v2, 4, v20
    s_lshl_b32 s47, s44, 10
    s_add_u32 s47, s47, 143360
    v_add_u32 v20, s47, v20
    s_waitcnt lgkmcnt(0)
    s_add_u32 s42, s42, 0x7f4a7c15
    s_addc_u32 s43, s43, 0x9e3779b9
    v_mov_b32 v30, s42
    v_mov_b32 v31, s43
L_xw:
    v_cndmask_b32 v32, 0, v64, s[20:21]
    v_cndmask_b32 v33, 0, v65, s[20:21]
    v_cndmask_b32 v34, 0, v66, s[20:21]
    v_cndmask_b32 v35, 0, v67, s[20:21]
    s_lshl_b64 s[20:21], s[20:21], 2
    v_xor_b32 v141, 32, v8
    v_cndmask_b32 v36, 0, v64, s[20:21]
    v_cndmask_b32 v37, 0, v65, s[20:21]
    v_cndmask_b32 v38, 0, v66, s[20:21]
    v_cndmask_b32 v39, 0, v67, s[20:21]
    s_lshl_b64 s[20:21], s[20:21], 2
    v_xor_b32 v142, 64, v8
    v_cndmask_b32 v40, 0, v64, s[20:21]
    v_cndmask_b32 v41, 0, v65, s[20:21]
    v_cndmask_b32 v42, 0, v66, s[20:21]
    v_cndmask_b32 v43, 0, v67, s[20:21]
    s_lshl_b64 s[20:21], s[20:21], 2
    v_xor_b32 v143, 96, v8
    v_cndmask_b32 v44, 0, v64, s[20:21]
    v_cndmask_b32 v45, 0, v65, s[20:21]
    v_cndmask_b32 v46, 0, v66, s[20:21]
    v_cndmask_b32 v47, 0, v67, s[20:21]
    s_lshl_b64 s[20:21], s[20:21], 2
    v_xor_b32 v144, 128, v8
    v_cndmask_b32 v48, 0, v64, s[20:21]
    v_cndmask_b32 v49, 0, v65, s[20:21]
    v_cndmask_b32 v50, 0, v66, s[20:21]
    v_cndmask_b32 v51, 0, v67, s[20:21]
    s_lshl_b64 s[20:21], s[20:21], 2
    v_xor_b32 v145, 160, v8
    v_cndmask_b32 v52, 0, v64, s[20:21]
    v_cndmask_b32 v53, 0, v65, s[20:21]
    v_cndmask_b32 v54, 0, v66, s[20:21]
    v_cndmask_b32 v55, 0, v67, s[20:21]
    s_lshl_b64 s[20:21], s[20:21], 2
    v_xor_b32 v146, 192, v8
    v_cndmask_b32 v56, 0, v64, s[20:21]
    v_cndmask_b32 v57, 0, v65, s[20:21]
    v_cndmask_b32 v58, 0, v66, s[20:21]
    v_cndmask_b32 v59, 0, v67, s[20:21]
    s_lshl_b64 s[20:21], s[20:21], 2
    v_xor_b32 v147, 224, v8
    v_cndmask_b32 v60, 0, v64, s[20:21]
    v_cndmask_b32 v61, 0, v65, s[20:21]
    v_cndmask_b32 v62, 0, v66, s[20:21]
    v_cndmask_b32 v63, 0, v67, s[20:21]
    s_lshl_b32 s47, s44, 3
    s_add_u32 s47, s47, 8
    s_mov_b32 s53, 0x2000000
L_sp_3:
    ds_read_b32 v23, v17 offset:0
    s_sub_u32 s53, s53, 1
    s_cbranch_scc1 L_end
    s_waitcnt lgkmcnt(0)
    v_readfirstlane_b32 s54, v23
    s_cmp_ge_i32 s54, s47
    s_cbranch_scc1 L_sd_4
    s_sleep 1
    s_branch L_sp_3
L_sd_4:
    ds_read_b64_tr_b16 v[64:65], v8 offset:0
    ds_read_b64_tr_b16 v[66:67], v8 offset:4096
    ds_read_b64_tr_b16 v[68:69], v141 offset:0
    ds_read_b64_tr_b16 v[70:71], v141 offset:4096
    ds_read_b64_tr_b16 v[72:73], v142 offset:0
    ds_read_b64_tr_b16 v[74:75], v142 offset:4096
    ds_read_b64_tr_b16 v[76:77], v143 offset:0
    ds_read_b64_tr_b16 v[78:79], v143 offset:4096
    ds_read_b64_tr_b16 v[80:81], v144 offset:0
    ds_read_b64_tr_b16 v[82:83], v144 offset:4096
    ds_read_b64_tr_b16 v[84:85], v145 offset:0
    ds_read_b64_tr_b16 v[86:87], v145 offset:4096
    ds_read_b64_tr_b16 v[88:89], v146 offset:0
    ds_read_b64_tr_b16 v[90:91], v146 offset:4096
    ds_read_b64_tr_b16 v[92:93], v147 offset:0
    ds_read_b64_tr_b16 v[94:95], v147 offset:4096
    s_waitcnt lgkmcnt(14)
    v_mfma_f32_16x16x32_bf16 v[24:27], v[64:67], v[32:35], 0
    s_waitcnt lgkmcnt(12)
    v_mfma_f32_16x16x32_bf16 v[24:27], v[68:71], v[36:39], v[24:27]
    s_waitcnt lgkmcnt(10)
    v_mfma_f32_16x16x32_bf16 v[24:27], v[72:75], v[40:43], v[24:27]
    s_waitcnt lgkmcnt(8)
    v_mfma_f32_16x16x32_bf16 v[24:27], v[76:79], v[44:47], v[24:27]
    s_waitcnt lgkmcnt(6)
    v_mfma_f32_16x16x32_bf16 v[24:27], v[80:83], v[48:51], v[24:27]
    s_waitcnt lgkmcnt(4)
    v_mfma_f32_16x16x32_bf16 v[24:27], v[84:87], v[52:55], v[24:27]
    s_waitcnt lgkmcnt(2)
    v_mfma_f32_16x16x32_bf16 v[24:27], v[88:91], v[56:59], v[24:27]
    s_waitcnt lgkmcnt(0)
    v_mfma_f32_16x16x32_bf16 v[24:27], v[92:95], v[60:63], v[24:27]
    v_add_u32 v22, 143360, v21
    s_nop 6
    ds_write_b128 v20, v[24:27]
    s_mov_b64 exec, 1
    ds_add_rtn_u32 v23, v17, v18 offset:4
    s_mov_b64 exec, -1
    s_waitcnt lgkmcnt(0)
    v_readfirstlane_b32 s54, v23
    s_cmp_lg_u32 s54, 7
    s_cbranch_scc1 L_noQ
    ds_read_b128 v[32:35], v22 offset:0
    ds_read_b128 v[36:39], v22 offset:1024
    ds_read_b128 v[40:43], v22 offset:2048
    ds_read_b128 v[44:47], v22 offset:3072
    ds_read_b128 v[48:51], v22 offset:4096
    ds_read_b128 v[52:55], v22 offset:5120
    ds_read_b128 v[56:59], v22 offset:6144
    ds_read_b128 v[60:63], v22 offset:7168
    s_waitcnt lgkmcnt(6)
    v_pk_add_f32 v[32:33], v[32:33], v[36:37]
    v_pk_add_f32 v[34:35], v[34:35], v[38:39]
    s_waitcnt lgkmcnt(4)
    v_pk_add_f32 v[40:41], v[40:41], v[44:45]
    v_pk_add_f32 v[42:43], v[42:43], v[46:47]
    s_waitcnt lgkmcnt(2)
    v_pk_add_f32 v[48:49], v[48:49], v[52:53]
    v_pk_add_f32 v[50:51], v[50:51], v[54:55]
    s_waitcnt lgkmcnt(0)
    v_pk_add_f32 v[56:57], v[56:57], v[60:61]
    v_pk_add_f32 v[58:59], v[58:59], v[62:63]
    v_pk_add_f32 v[32:33], v[32:33], v[40:41]
    v_pk_add_f32 v[34:35], v[34:35], v[42:43]
    v_pk_add_f32 v[48:49], v[48:49], v[56:57]
    v_pk_add_f32 v[50:51], v[50:51], v[58:59]
    v_pk_add_f32 v[32:33], v[32:33], v[48:49]
    v_pk_add_f32 v[34:35], v[34:35], v[50:51]
    s_cmp_lg_u32 s4, 0
    s_cbranch_scc1 L_qw
    v_mov_b32 v36, v32
    v_mov_b32 v37, v33
    v_mov_b32 v38, v34
    v_mov_b32 v39, v35
    v_permlane16_swap_b32 v32, v36
    v_permlane16_swap_b32 v33, v37
    v_permlane16_swap_b32 v34, v38
    v_permlane16_swap_b32 v35, v39
    v_pk_add_f32 v[32:33], v[32:33], v[36:37]
    v_pk_add_f32 v[34:35], v[34:35], v[38:39]
    s_mov_b32 exec_lo, 0xffff
    s_mov_b32 exec_hi, 0xffff
L_qw:
    v_cvt_pk_bf16_f32 v28, v32, v33
    v_cvt_pk_bf16_f32 v29, v34, v35
    global_store_dwordx4 v19, v[28:31], s[12:13] sc1
    s_mov_b64 exec, -1
L_noQ:
    s_getreg_b32 s32, hwreg(HW_REG_XCC_ID, 0, 4)
    s_cmp_lg_u32 s44, 4
    s_cbranch_scc1 L_notok
    s_waitcnt vmcnt(0)
    s_mov_b64 exec, 1
    s_lshl_b32 s47, s37, 4
    s_add_u32 s47, s47, 4096
    v_mov_b32 v22, s47
    v_mov_b32 v28, s32
    global_store_dwordx4 v22, v[28:31], s[12:13] sc1
    ds_write_b32 v17, v18 offset:44
    s_mov_b64 exec, -1
L_notok:
    s_mov_b32 s28, 0xff00ff00
    s_mov_b32 s29, 0xff00ff00
    s_mov_b32 s30, 0xff00ff
    s_mov_b32 s31, 0xff00ff
    v_xor_b32 v12, s44, v6
    v_lshlrev_b32 v12, 5, v12
    v_lshl_add_u32 v12, v7, 8, v12
    v_lshl_add_u32 v12, v4, 3, v12
    v_lshlrev_b32 v13, 1, v5
    v_xor_b32 v13, v13, v2
    s_lshl_b32 s47, s44, 13
    s_add_u32 s47, s47, 65536
    v_lshlrev_b32 v14, 8, v1
    v_add_u32 v14, s47, v14
    v_lshl_add_u32 v13, v13, 4, v14
    v_xor_b32 v14, 64, v13
    v_xor_b32 v15, 128, v13
    v_xor_b32 v16, 192, v13
    s_lshl_b32 s47, s37, 11
    s_add_u32 s47, s47, 1048576
    v_add_u32 v137, s47, v21
    s_lshl_b32 s49, s44, 5
    s_add_u32 s47, s47, s49
    v_lshlrev_b32 v129, 8, v5
    v_lshl_add_u32 v129, v2, 3, v129
    v_add_u32 v129, s47, v129
    s_lshl_b32 s47, s3, 16
    s_lshl_b32 s49, s33, 6
    s_add_u32 s47, s47, s49
    s_add_u32 s47, s47, 1048576
    s_lshl_b32 s49, s44, 13
    s_add_u32 s49, s49, s47
    v_bfe_u32 v131, v0, 1, 1
    v_lshlrev_b32 v131, 12, v131
    v_lshrrev_b32 v22, 5, v0
    v_lshl_add_u32 v131, v22, 11, v131
    v_and_b32 v20, 1, v0
    v_lshl_add_u32 v131, v20, 5, v131
    v_and_b32 v20, 16, v0
    v_add3_u32 v131, v131, v20, s49
    s_and_b32 s49, s44, 1
    s_lshl_b32 s49, s49, 15
    s_add_u32 s47, s47, s49
    v_lshrrev_b32 v133, 3, v0
    v_lshlrev_b32 v133, 11, v133
    v_lshl_add_u32 v133, v5, 3, v133
    v_add_u32 v133, s47, v133
    v_add_u32 v134, 0x4000, v133
    s_lshl_b32 s47, s3, 3
    s_add_u32 s47, s47, s44
    s_lshl_b32 s47, s47, 1
    s_add_u32 s47, s47, s48
    s_lshl_b32 s47, s47, 11
    s_add_u32 s47, s47, 65536
    v_lshrrev_b32 v26, 5, v0
    v_and_b32 v25, 0x1f0, v21
    v_add_u32 v24, s47, v21
    s_lshl3_add_u32 s47, s35, s44
    s_bitcmp1_b32 0x22222222, s47
    s_cselect_b32 s5, 1, 0
    v_mov_b32 v36, 0
    v_mov_b32 v37, 0
    v_mov_b32 v38, s42
    v_mov_b32 v39, s43
    s_lshl_b32 s47, s3, 9
    s_add_u32 s47, s47, 4096
    v_add_u32 v25, s47, v25
    s_lshl_b32 s47, s44, 1
    v_xor_b32 v8, s47, v6
    v_lshlrev_b32 v8, 5, v8
    v_lshl_add_u32 v8, v7, 9, v8
    v_lshl_add_u32 v8, v4, 3, v8
    v_add_u32 v8, 65536, v8
    v_xor_b32 v9, 32, v8
    v_and_b32 v27, 1, v0
    v_lshlrev_b32 v10, 8, v27
    v_lshl_add_u32 v10, v2, 4, v10
    v_add_u32 v10, 131584, v10
    v_lshlrev_b32 v11, 4, v4
    v_bfe_u32 v19, v0, 2, 1
    v_lshl_add_u32 v11, v19, 3, v11
    v_and_b32 v19, 0x38, v0
    v_lshl_add_u32 v11, v19, 3, v11
    v_add_u32 v11, 131584, v11
    v_bfe_u32 v19, v0, 4, 1
    v_lshlrev_b32 v19, 2, v19
    v_lshl_add_u32 v19, v26, 1, v19
    v_lshl_add_u32 v19, v27, 3, v19
    v_bfe_u32 v20, v0, 1, 1
    v_lshl_add_u32 v19, v20, 12, v19
    s_lshl_b32 s47, s37, 4
    v_add_u32 v19, s47, v19
    s_lshr_b32 s50, s33, 2
    s_mov_b32 s20, 0xf000f
    s_mov_b32 s21, 0xf000f
    s_mov_b32 s22, 0xcccccccc
    s_mov_b32 s23, 0xcccccccc
    v_lshrrev_b32 v7, 3, v0
    s_and_b32 s47, s44, 1
    s_lshl_b32 s47, s47, 4
    s_lshl_b32 s49, s3, 5
    s_add_u32 s47, s47, s49
    s_and_b32 s51, s33, 3
    s_lshl_b32 s51, s51, 7
    s_lshl_b32 s47, s47, 7
    s_lshl_b32 s50, s50, 4
    s_add_u32 s47, s47, s50
    s_add_u32 s47, s47, 32768
    v_lshl_add_u32 v7, v7, 7, s47
    s_mov_b32 s24, 0xfffe0000
    v_mov_b32 v3, 0x8000
    v_lshl_add_u32 v7, v27, 10, v7
    s_mov_b32 s26, 0x3030303
    s_mov_b32 s27, 0x3030303
    s_lshr_b32 s38, s37, 2
    s_lshl_b32 s38, s38, 10
    s_and_b32 s47, s44, 1
    s_lshl_b32 s47, s47, 9
    s_add_u32 s38, s38, s47
    s_add_u32 s38, s38, s51
    s_add_u32 s38, s38, 524288
    s_lshl_b32 s39, s34, 5
    s_add_u32 s39, s39, s33
    s_lshl_b32 s39, s39, 10
    s_add_u32 s39, s39, 524288
    s_lshl_b32 s47, s44, 7
    s_add_u32 s47, s47, s39
    s_add_u32 s62, s12, s47
    s_addc_u32 s63, s13, 0
    s_lshl_b32 s49, s34, 3
    s_add_u32 s49, s49, s33
    s_and_b32 s49, s49, 15
    s_lshl_b32 s49, s49, 1
    s_lshl_b32 s47, s44, 3
    s_sub_u32 s47, s47, s49
    v_lshrrev_b32 v142, 1, v0
    v_add_u32 v142, s47, v142
    v_and_b32 v141, 3, v142
    v_lshlrev_b32 v141, 4, v141
    v_bfe_u32 v143, v142, 2, 1
    v_lshl_add_u32 v141, v143, 3, v141
    v_bfe_u32 v143, v142, 3, 2
    v_lshl_add_u32 v141, v143, 6, v141
    v_and_b32 v142, 1, v0
    v_lshl_add_u32 v141, v142, 2, v141
    s_lshr_b32 s47, s44, 2
    s_lshl_b32 s47, s47, 8
    s_add_u32 s47, s47, 131584
    v_add_u32 v141, s47, v141
    s_mov_b32 s53, 0x2000000
L_sp_5:
    ds_read_b32 v23, v17 offset:0
    s_sub_u32 s53, s53, 1
    s_cbranch_scc1 L_end
    s_waitcnt lgkmcnt(0)
    v_readfirstlane_b32 s54, v23
    s_cmp_ge_i32 s54, 104
    s_cbranch_scc1 L_sd_6
    s_sleep 1
    s_branch L_sp_5
L_sd_6:
    s_cmp_lg_u32 s44, 0
    s_cbranch_scc1 L_tk_skip
    global_load_dwordx4 v[40:43], v25, s[12:13] sc1
L_tk_skip:
    global_load_dwordx4 v[32:35], v24, s[12:13] sc1
    s_cmp_lg_u32 s5, 0
    s_cbranch_scc0 1f
    global_load_dwordx4 v[36:39], v24, s[12:13] offset:1024 sc1
1:
    s_mov_b32 s53, 0x2000000
L_sp_7:
    ds_read_b32 v23, v17 offset:44
    s_sub_u32 s53, s53, 1
    s_cbranch_scc1 L_end
    s_waitcnt lgkmcnt(0)
    v_readfirstlane_b32 s54, v23
    s_cmp_ge_i32 s54, 1
    s_cbranch_scc1 L_sd_8
    s_sleep 1
    s_branch L_sp_7
L_sd_8:
    s_lshl_b32 s47, s44, 3
    s_add_u32 s47, s47, 72
    s_mov_b32 s53, 0x2000000
L_sp_9:
    ds_read_b32 v23, v17 offset:0
    s_sub_u32 s53, s53, 1
    s_cbranch_scc1 L_end
    s_waitcnt lgkmcnt(0)
    v_readfirstlane_b32 s54, v23
    s_cmp_ge_i32 s54, s47
    s_cbranch_scc1 L_sd_10
    s_sleep 1
    s_branch L_sp_9
L_sd_10:
    ds_read_b128 v[96:99], v13 offset:0
    ds_read_b128 v[100:103], v14 offset:0
    ds_read_b128 v[104:107], v15 offset:0
    ds_read_b128 v[108:111], v16 offset:0
    ds_read_b128 v[112:115], v13 offset:4096
    ds_read_b128 v[116:119], v14 offset:4096
    ds_read_b128 v[120:123], v15 offset:4096
    ds_read_b128 v[124:127], v16 offset:4096
    v_and_b32 v13, 0x7ff, v129
    v_add_u32 v13, 139264, v13
    ds_read_b32 v130, v13
    v_add_u32 v13, 139264, v21
    ds_read_b32 v138, v13
    ds_read_b32 v139, v13 offset:1024
    v_bfe_u32 v13, v131, 11, 5
    v_and_b32 v14, 63, v131
    v_lshl_add_u32 v13, v13, 6, v14
    v_add_u32 v13, 141312, v13
    ds_read_b32 v132, v13
    v_bfe_u32 v13, v133, 11, 5
    v_and_b32 v14, 63, v133
    v_lshl_add_u32 v13, v13, 6, v14
    v_add_u32 v13, 141312, v13
    ds_read_b32 v135, v13
    ds_read_b32 v136, v13 offset:512
    s_waitcnt lgkmcnt(0)
    v_bfi_b32 v130, v130, 0, 1
    v_and_b32 v132, 1, v132
    s_mov_b64 exec, 1
    ds_add_u32 v17, v18 offset:8
    s_mov_b64 exec, -1
    s_mov_b32 s53, 0x200000
    s_mul_i32 s47, s44, 272
    s_add_u32 s47, s47, 132096
    v_and_b32 v26, 32, v0
    v_lshlrev_b32 v26, 2, v26
    v_lshl_add_u32 v26, v1, 3, v26
    v_bfe_u32 v23, v0, 4, 1
    v_lshl_add_u32 v26, v23, 2, v26
    v_add_u32 v26, s47, v26
    s_branch L_gA_chk
L_gA:
    global_load_dwordx4 v[32:35], v24, s[12:13] sc1
    s_cmp_lg_u32 s5, 0
    s_cbranch_scc0 1f
    global_load_dwordx4 v[36:39], v24, s[12:13] offset:1024 sc1
1:
    s_sub_u32 s53, s53, 1
    s_cbranch_scc1 L_end
L_gA_chk:
    s_waitcnt vmcnt(0)
    v_cmp_ne_u64 s[56:57], s[42:43], v[34:35]
    v_cmp_ne_u64 vcc, s[42:43], v[38:39]
    s_or_b64 s[56:57], s[56:57], vcc
    s_mov_b64 exec, s[56:57]
    s_cbranch_execnz L_gA
    s_mov_b64 exec, -1
    v_lshlrev_b32 v44, 16, v32
    v_and_b32 v45, 0xffff0000, v32
    v_lshlrev_b32 v46, 16, v33
    v_and_b32 v47, 0xffff0000, v33
    v_lshlrev_b32 v48, 16, v36
    v_and_b32 v49, 0xffff0000, v36
    v_lshlrev_b32 v50, 16, v37
    v_and_b32 v51, 0xffff0000, v37
    v_pk_add_f32 v[44:45], v[44:45], v[48:49]
    v_pk_add_f32 v[46:47], v[46:47], v[50:51]
    s_nop 1
    v_permlane16_swap_b32 v44, v46
    v_permlane16_swap_b32 v45, v47
    v_pk_add_f32 v[44:45], v[44:45], v[46:47]
    v_cvt_pk_bf16_f32 v32, v44, v45
    ds_write_b32 v26, v32
    s_cmp_lg_u32 s44, 0
    s_cbranch_scc1 L_tk_done
    s_branch L_tk_chk
L_tk:
    global_load_dwordx4 v[40:43], v25, s[12:13] sc1
    s_sub_u32 s53, s53, 1
    s_cbranch_scc1 L_end
    s_waitcnt vmcnt(0)
L_tk_chk:
    v_cmp_ne_u64 vcc, s[42:43], v[42:43]
    s_cbranch_vccnz L_tk
    v_cmp_ne_u32 vcc, s32, v40
    s_mov_b64 exec, vcc
    ds_write_b32 v17, v18 offset:24
    s_mov_b64 exec, -1
L_tk_done:
    s_mov_b64 exec, 1
    ds_add_u32 v17, v18 offset:12
    s_mov_b64 exec, -1
    v_mul_u32_u24 v24, 272, v5
    v_lshl_add_u32 v24, v2, 4, v24
    v_add_u32 v24, 132096, v24
    s_mov_b32 s53, 0x2000000
L_sp_11:
    ds_read_b32 v23, v17 offset:12
    ds_read_b128 v[32:35], v24 offset:0
    ds_read_b128 v[36:39], v24 offset:64
    ds_read_b128 v[40:43], v24 offset:128
    ds_read_b128 v[44:47], v24 offset:192
    ds_read_b32 v140, v17 offset:24
    s_sub_u32 s53, s53, 1
    s_cbranch_scc1 L_end
    s_waitcnt lgkmcnt(0)
    v_readfirstlane_b32 s54, v23
    s_cmp_ge_i32 s54, 8
    s_cbranch_scc0 L_sp_11
    v_mfma_f32_16x16x32_bf16 v[48:51], v[96:99], v[32:35], 0
    v_mfma_f32_16x16x32_bf16 v[52:55], v[112:115], v[32:35], 0
    v_mfma_f32_16x16x32_bf16 v[48:51], v[100:103], v[36:39], v[48:51]
    v_mfma_f32_16x16x32_bf16 v[52:55], v[116:119], v[36:39], v[52:55]
    v_mfma_f32_16x16x32_bf16 v[48:51], v[104:107], v[40:43], v[48:51]
    v_mfma_f32_16x16x32_bf16 v[52:55], v[120:123], v[40:43], v[52:55]
    v_mfma_f32_16x16x32_bf16 v[48:51], v[108:111], v[44:47], v[48:51]
    v_mfma_f32_16x16x32_bf16 v[52:55], v[124:127], v[44:47], v[52:55]
    s_mov_b32 s47, 0x3e0293ee
    v_lshlrev_b32 v25, 5, v5
    v_add_u32 v25, 134400, v25
    s_lshl_b32 s49, s44, 2
    v_add_u32 v26, s49, v25
    v_lshlrev_b32 v24, 7, v2
    v_lshl_add_u32 v24, v5, 4, v24
    v_add_u32 v24, 135168, v24
    v_cndmask_b32 v48, v48, v52, s[28:29]
    v_cndmask_b32 v49, v49, v53, s[28:29]
    v_cndmask_b32 v50, v50, v54, s[28:29]
    v_cndmask_b32 v51, v51, v55, s[28:29]
    v_mul_f32 v48, s47, v48
    v_mul_f32 v49, s47, v49
    v_mul_f32 v50, s47, v50
    v_mul_f32 v51, s47, v51
    v_max3_f32 v52, v48, v49, v50
    v_max_f32 v52, v52, v51
    s_nop 1
    v_max_f32_dpp v52, v52, v52 row_ror:8 row_mask:0xf bank_mask:0xf
    v_mov_b32 v53, v52
    s_nop 1
    v_permlane16_swap_b32 v52, v53
    v_max_f32 v52, v52, v53
    v_mov_b32 v53, v52
    s_nop 1
    v_permlane32_swap_b32 v52, v53
    v_max_f32 v52, v52, v53
    s_mov_b64 exec, 0xff
    ds_write_b32 v26, v52
    s_mov_b64 exec, 1
    ds_add_u32 v17, v18 offset:16
    s_mov_b64 exec, -1
    s_lshl_b32 s49, s44, 9
    v_and_b32 v27, 8, v0
    v_add3_u32 v27, v27, v24, s49
    v_readfirstlane_b32 s60, v140
    s_mov_b32 s61, 0
    s_mov_b32 s53, 0x2000000
L_sp_12:
    ds_read_b32 v23, v17 offset:16
    ds_read_b128 v[56:59], v25
    ds_read_b128 v[60:63], v25 offset:16
    s_sub_u32 s53, s53, 1
    s_cbranch_scc1 L_end
    s_waitcnt lgkmcnt(0)
    v_readfirstlane_b32 s54, v23
    s_cmp_ge_i32 s54, 8
    s_cbranch_scc0 L_sp_12
    v_max3_f32 v52, v56, v57, v58
    v_max3_f32 v53, v59, v60, v61
    v_max3_f32 v52, v52, v62, v63
    v_max_f32 v52, v52, v53
    v_sub_f32 v48, v48, v52
    v_sub_f32 v49, v49, v52
    v_sub_f32 v50, v50, v52
    v_sub_f32 v51, v51, v52
    v_exp_f32 v48, v48
    v_exp_f32 v49, v49
    v_exp_f32 v50, v50
    v_exp_f32 v51, v51
    v_cvt_pk_bf16_f32 v54, v48, v49
    v_add_f32 v48, v48, v49
    v_cvt_pk_bf16_f32 v55, v50, v51
    ds_write_b64 v27, v[54:55]
    s_mov_b64 exec, 1
    ds_add_u32 v17, v18 offset:20
    s_mov_b64 exec, -1
    v_add_f32 v50, v50, v51
    v_add_f32 v48, v48, v50
    s_nop 1
    v_add_f32_dpp v48, v48, v48 row_ror:8 row_mask:0xf bank_mask:0xf
    v_mov_b32 v49, v48
    s_nop 1
    v_permlane16_swap_b32 v48, v49
    v_add_f32 v48, v48, v49
    v_mov_b32 v49, v48
    s_nop 1
    v_permlane32_swap_b32 v48, v49
    v_add_f32 v48, v48, v49
    s_mov_b64 exec, 0xff
    ds_write_b32 v26, v48 offset:256
    s_mov_b64 exec, 1
    ds_add_u32 v17, v18 offset:40
    s_mov_b64 exec, -1
    s_mov_b32 s53, 0x2000000
L_sp_13:
    ds_read_b32 v23, v17 offset:20
    ds_read_b32 v140, v17
    s_sub_u32 s53, s53, 1
    s_cbranch_scc1 L_end
    s_waitcnt lgkmcnt(0)
    v_readfirstlane_b32 s54, v23
    s_cmp_ge_i32 s54, 8
    s_cbranch_scc0 L_sp_13
    ds_read_b128 v[96:99], v24 offset:0
    ds_read_b128 v[100:103], v24 offset:512
    ds_read_b128 v[104:107], v24 offset:1024
    ds_read_b128 v[108:111], v24 offset:1536
    ds_read_b128 v[112:115], v24 offset:2048
    ds_read_b128 v[116:119], v24 offset:2560
    ds_read_b128 v[120:123], v24 offset:3072
    ds_read_b128 v[124:127], v24 offset:3584
    s_cmp_lg_u32 s44, 7
    s_cbranch_scc1 L_noML
    s_mov_b32 s53, 0x2000000
L_sp_14:
    ds_read_b32 v23, v17 offset:40
    ds_read_b128 v[56:59], v25 offset:256
    ds_read_b128 v[60:63], v25 offset:272
    s_sub_u32 s53, s53, 1
    s_cbranch_scc1 L_end
    s_waitcnt lgkmcnt(0)
    v_readfirstlane_b32 s54, v23
    s_cmp_ge_i32 s54, 8
    s_cbranch_scc0 L_sp_14
    s_lshl_b32 s47, s37, 7
    s_add_u32 s47, s47, 32768
    v_add_u32 v26, s47, v21
    v_mov_b32 v28, v52
    s_cmp_lg_u64 s[60:61], 0
    s_waitcnt lgkmcnt(0)
    v_pk_add_f32 v[56:57], v[56:57], v[58:59]
    v_pk_add_f32 v[60:61], v[60:61], v[62:63]
    v_pk_add_f32 v[56:57], v[56:57], v[60:61]
    v_add_f32 v29, v56, v57
    s_mov_b64 exec, 0xff
    s_cbranch_scc1 L_ml_g
    global_store_dwordx4 v26, v[28:31], s[12:13]
    s_branch L_ml_d
L_ml_g:
    global_store_dwordx4 v26, v[28:31], s[12:13] sc1
L_ml_d:
    s_mov_b64 exec, -1
L_noML:
    v_readfirstlane_b32 s54, v140
    s_cmp_ge_i32 s54, 160
    s_cbranch_scc1 L_sk_16
    s_mov_b32 s53, 0x2000000
L_sp_15:
    ds_read_b32 v23, v17 offset:0
    s_sub_u32 s53, s53, 1
    s_cbranch_scc1 L_end
    s_waitcnt lgkmcnt(0)
    v_readfirstlane_b32 s54, v23
    s_cmp_ge_i32 s54, 160
    s_cbranch_scc1 L_sd_17
    s_sleep 1
    s_branch L_sp_15
L_sd_17:
L_sk_16:
    ds_read_b64_tr_b16 v[64:65], v12 offset:0
    ds_read_b64_tr_b16 v[66:67], v12 offset:4096
    ds_read_b64_tr_b16 v[68:69], v12 offset:8192
    ds_read_b64_tr_b16 v[70:71], v12 offset:12288
    ds_read_b64_tr_b16 v[72:73], v12 offset:16384
    ds_read_b64_tr_b16 v[74:75], v12 offset:20480
    ds_read_b64_tr_b16 v[76:77], v12 offset:24576
    ds_read_b64_tr_b16 v[78:79], v12 offset:28672
    s_waitcnt lgkmcnt(6)
    v_mfma_f32_16x16x32_bf16 v[24:27], v[64:67], v[96:99], 0
    s_waitcnt lgkmcnt(4)
    v_mfma_f32_16x16x32_bf16 v[24:27], v[68:71], v[100:103], v[24:27]
    s_waitcnt lgkmcnt(2)
    v_mfma_f32_16x16x32_bf16 v[24:27], v[72:75], v[104:107], v[24:27]
    s_waitcnt lgkmcnt(0)
    v_mfma_f32_16x16x32_bf16 v[24:27], v[76:79], v[108:111], v[24:27]
    s_cmp_ge_i32 s54, 176
    s_cbranch_scc1 L_sk_19
    s_mov_b32 s53, 0x2000000
L_sp_18:
    ds_read_b32 v23, v17 offset:0
    s_sub_u32 s53, s53, 1
    s_cbranch_scc1 L_end
    s_waitcnt lgkmcnt(0)
    v_readfirstlane_b32 s54, v23
    s_cmp_ge_i32 s54, 176
    s_cbranch_scc1 L_sd_20
    s_sleep 1
    s_branch L_sp_18
L_sd_20:
L_sk_19:
    ds_read_b64_tr_b16 v[80:81], v12 offset:32768
    ds_read_b64_tr_b16 v[82:83], v12 offset:36864
    ds_read_b64_tr_b16 v[84:85], v12 offset:40960
    ds_read_b64_tr_b16 v[86:87], v12 offset:45056
    s_waitcnt lgkmcnt(2)
    v_mfma_f32_16x16x32_bf16 v[24:27], v[80:83], v[112:115], v[24:27]
    s_waitcnt lgkmcnt(0)
    v_mfma_f32_16x16x32_bf16 v[24:27], v[84:87], v[116:119], v[24:27]
    s_cmp_ge_i32 s54, 184
    s_cbranch_scc1 L_sk_22
    s_mov_b32 s53, 0x2000000
L_sp_21:
    ds_read_b32 v23, v17 offset:0
    s_sub_u32 s53, s53, 1
    s_cbranch_scc1 L_end
    s_waitcnt lgkmcnt(0)
    v_readfirstlane_b32 s54, v23
    s_cmp_ge_i32 s54, 184
    s_cbranch_scc1 L_sd_23
    s_sleep 1
    s_branch L_sp_21
L_sd_23:
L_sk_22:
    ds_read_b64_tr_b16 v[88:89], v12 offset:49152
    ds_read_b64_tr_b16 v[90:91], v12 offset:53248
    s_waitcnt lgkmcnt(0)
    v_mfma_f32_16x16x32_bf16 v[24:27], v[88:91], v[120:123], v[24:27]
    s_cmp_ge_u32 s44, 4
    s_cbranch_scc1 L_nomlp
    s_mov_b64 exec, s[26:27]
    global_load_dwordx4 v[32:35], v7, s[12:13] sc1
    s_mov_b64 exec, -1
L_nomlp:
    s_cmp_ge_i32 s54, 192
    s_cbranch_scc1 L_sk_25
    s_mov_b32 s53, 0x2000000
L_sp_24:
    ds_read_b32 v23, v17 offset:0
    s_sub_u32 s53, s53, 1
    s_cbranch_scc1 L_end
    s_waitcnt lgkmcnt(0)
    v_readfirstlane_b32 s54, v23
    s_cmp_ge_i32 s54, 192
    s_cbranch_scc0 L_sp_24
L_sk_25:
    ds_read_b64_tr_b16 v[92:93], v12 offset:57344
    ds_read_b64_tr_b16 v[94:95], v12 offset:61440
    s_waitcnt lgkmcnt(0)
    v_mfma_f32_16x16x32_bf16 v[24:27], v[92:95], v[124:127], v[24:27]
    s_mov_b64 exec, s[30:31]
    s_cmp_lg_u64 s[60:61], 0
    s_nop 5
    v_cvt_pk_bf16_f32 v28, v24, v25
    v_cvt_pk_bf16_f32 v29, v26, v27
    v_and_or_b32 v28, v28, -2, v130
    s_cbranch_scc1 L_b_g
    global_store_dwordx2 v129, v[28:29], s[12:13]
    s_branch L_b_d
L_b_g:
    global_store_dwordx2 v129, v[28:29], s[12:13] sc1
L_b_d:
    s_mov_b64 exec, -1
    s_cmp_ge_u32 s44, 4
    s_cbranch_scc1 L_noB1w
    s_lshr_b32 s47, s44, 1
    s_mul_i32 s47, s47, 10
    s_add_u32 s47, s47, 198
    s_mov_b32 s53, 0x2000000
L_sp_26:
    ds_read_b32 v23, v17 offset:0
    s_sub_u32 s53, s53, 1
    s_cbranch_scc1 L_end
    s_waitcnt lgkmcnt(0)
    v_readfirstlane_b32 s54, v23
    s_cmp_ge_i32 s54, s47
    s_cbranch_scc1 L_sd_27
    s_sleep 1
    s_branch L_sp_26
L_sd_27:
    global_load_dwordx2 v[100:101], v133, s[12:13] sc1
    global_load_dwordx2 v[104:105], v134, s[12:13] sc1
    s_mov_b32 s53, 0x200000
    s_and_b32 s47, s44, 1
    s_lshl_b32 s47, s47, 2
    v_add_u32 v13, s47, v17
    v_add_u32 v14, s38, v21
    s_mov_b64 exec, s[26:27]
    s_waitcnt vmcnt(3)
    s_branch L_gM_chk
L_gM:
    global_load_dwordx4 v[32:35], v7, s[12:13] sc1
    s_sub_u32 s53, s53, 1
    s_cbranch_scc1 L_end
    s_waitcnt vmcnt(0)
L_gM_chk:
    v_cmp_ne_u64 vcc, s[42:43], v[34:35]
    s_mov_b64 exec, vcc
    s_cbranch_execnz L_gM
    s_mov_b64 exec, -1
    s_nop 0
    v_max_f32_dpp v44, v32, v32 quad_perm:[1,0,3,2] row_mask:0xf bank_mask:0xf
    s_nop 1
    v_max_f32_dpp v44, v44, v44 row_ror:8 row_mask:0xf bank_mask:0xf
    v_mov_b32 v45, v44
    s_nop 1
    v_permlane16_swap_b32 v44, v45
    v_max_f32 v44, v44, v45
    v_mov_b32 v45, v44
    s_nop 1
    v_permlane32_swap_b32 v44, v45
    v_max_f32 v44, v44, v45
    v_sub_f32 v32, v32, v44
    v_exp_f32 v36, v32
    s_nop 0
    v_mul_f32 v33, v33, v36
    s_nop 1
    v_add_f32_dpp v33, v33, v33 quad_perm:[1,0,3,2] row_mask:0xf bank_mask:0xf
    s_nop 1
    v_add_f32_dpp v33, v33, v33 row_ror:8 row_mask:0xf bank_mask:0xf
    v_mov_b32 v45, v33
    s_nop 1
    v_permlane16_swap_b32 v33, v45
    v_add_f32 v33, v33, v45
    v_mov_b32 v45, v33
    s_nop 1
    v_permlane32_swap_b32 v33, v45
    v_add_f32 v33, v33, v45
    v_rcp_f32 v33, v33
    s_mov_b32 s53, 0x200000
    v_mul_f32 v36, v36, v33
    ds_swizzle_b32 v46, v36 offset:0x0018
    ds_swizzle_b32 v47, v36 offset:0x0038
    s_waitcnt lgkmcnt(0)
    s_branch L_gB_chk
L_gB:
    ds_read_b32 v23, v13 offset:32
    s_waitcnt lgkmcnt(0)
    v_readfirstlane_b32 s54, v23
    s_cmp_lg_u32 s54, 0
    s_cbranch_scc1 L_B1_done
    global_load_dwordx2 v[100:101], v133, s[12:13] sc1
    global_load_dwordx2 v[104:105], v134, s[12:13] sc1
    s_sub_u32 s53, s53, 1
    s_cbranch_scc1 L_end
L_gB_chk:
    s_waitcnt vmcnt(0)
    v_xor_b32 v102, v100, v135
    v_xor_b32 v103, v104, v136
    v_and_b32 v102, v102, v103
    v_and_b32 v102, 1, v102
    v_cmp_eq_u32 vcc, 0, v102
    s_mov_b64 exec, vcc
    s_cbranch_execnz L_gB
    s_mov_b64 exec, 1
    ds_add_rtn_u32 v23, v13, v18 offset:32
    s_mov_b64 exec, -1
    v_lshlrev_b32 v36, 16, v100
    v_and_b32 v37, 0xffff0000, v100
    v_lshlrev_b32 v38, 16, v101
    v_and_b32 v39, 0xffff0000, v101
    v_lshlrev_b32 v40, 16, v104
    v_and_b32 v41, 0xffff0000, v104
    v_lshlrev_b32 v42, 16, v105
    v_and_b32 v43, 0xffff0000, v105
    v_and_or_b32 v36, v36, s24, v3
    v_and_or_b32 v40, v40, s24, v3
    v_pk_mul_f32 v[36:37], v[36:37], v[46:47] op_sel_hi:[1,0]
    v_pk_mul_f32 v[38:39], v[38:39], v[46:47] op_sel_hi:[1,0]
    v_pk_fma_f32 v[36:37], v[40:41], v[46:47], v[36:37] op_sel:[0,1,0]
    v_pk_fma_f32 v[38:39], v[42:43], v[46:47], v[38:39] op_sel:[0,1,0]
    s_nop 1
    v_permlane32_swap_b32 v36, v38
    v_permlane32_swap_b32 v37, v39
    v_pk_add_f32 v[36:37], v[36:37], v[38:39]
    s_nop 1
    v_permlane16_swap_b32 v36, v37
    v_add_f32 v36, v36, v37
    s_nop 1
    v_add_f32_dpp v36, v36, v36 row_ror:8 row_mask:0xf bank_mask:0xf
    v_mov_b32 v37, v36
    s_nop 1
    v_permlane16_swap_b32 v36, v37
    v_cvt_pk_bf16_f32 v28, v36, v37
    v_mov_b32 v29, v28
    s_waitcnt lgkmcnt(0)
    v_readfirstlane_b32 s54, v23
    v_permlane32_swap_b32 v28, v29
    s_cmp_lg_u32 s54, 0
    s_cbranch_scc1 L_B1_done
    s_mov_b64 exec, 0xff
    global_store_dwordx4 v14, v[28:31], s[12:13] sc1
L_B1_done:
    s_mov_b64 exec, -1
    s_branch L_noB1
L_noB1w:
    s_waitcnt vmcnt(0)
L_noB1:
    s_mov_b32 s53, 0x2000000
L_sp_28:
    ds_read_b32 v23, v17 offset:0
    s_sub_u32 s53, s53, 1
    s_cbranch_scc1 L_end
    s_waitcnt lgkmcnt(0)
    v_readfirstlane_b32 s54, v23
    s_cmp_ge_i32 s54, 224
    s_cbranch_scc1 L_sd_29
    s_sleep 1
    s_branch L_sp_28
L_sd_29:
    ds_read_b64_tr_b16 v[64:65], v8 offset:0
    ds_read_b64_tr_b16 v[68:69], v9 offset:0
    ds_read_b64_tr_b16 v[66:67], v8 offset:8192
    ds_read_b64_tr_b16 v[70:71], v9 offset:8192
    ds_read_b64_tr_b16 v[72:73], v8 offset:16384
    ds_read_b64_tr_b16 v[76:77], v9 offset:16384
    ds_read_b64_tr_b16 v[74:75], v8 offset:24576
    ds_read_b64_tr_b16 v[78:79], v9 offset:24576
    s_cmp_ge_i32 s54, 232
    s_cbranch_scc1 L_sk_31
    s_mov_b32 s53, 0x2000000
L_sp_30:
    ds_read_b32 v23, v17 offset:0
    s_sub_u32 s53, s53, 1
    s_cbranch_scc1 L_end
    s_waitcnt lgkmcnt(0)
    v_readfirstlane_b32 s54, v23
    s_cmp_ge_i32 s54, 232
    s_cbranch_scc0 L_sp_30
L_sk_31:
    s_load_dwordx16 s[64:79], s[62:63], 0 glc
    s_load_dwordx16 s[80:95], s[62:63], 64 glc
    s_cmp_ge_i32 s54, 248
    s_cbranch_scc1 L_sk_33
    s_mov_b32 s53, 0x2000000
L_sp_32:
    ds_read_b32 v23, v17 offset:0
    s_sub_u32 s53, s53, 1
    s_cbranch_scc1 L_end
    s_waitcnt lgkmcnt(0)
    v_readfirstlane_b32 s54, v23
    s_cmp_ge_i32 s54, 248
    s_cbranch_scc0 L_sp_32
L_sk_33:
    ds_read_b64_tr_b16 v[80:81], v8 offset:32768
    ds_read_b64_tr_b16 v[84:85], v9 offset:32768
    ds_read_b64_tr_b16 v[82:83], v8 offset:40960
    ds_read_b64_tr_b16 v[86:87], v9 offset:40960
    ds_read_b64_tr_b16 v[88:89], v8 offset:49152
    ds_read_b64_tr_b16 v[92:93], v9 offset:49152
    s_mov_b32 s53, 0x200000
    s_branch L_gO_c
L_gO:
    s_load_dwordx16 s[64:79], s[62:63], 0 glc
    s_load_dwordx16 s[80:95], s[62:63], 64 glc
    s_sub_u32 s53, s53, 1
    s_cbranch_scc1 L_end
L_gO_c:
    s_waitcnt lgkmcnt(0)
    s_xor_b64 s[66:67], s[66:67], s[42:43]
    s_xor_b64 s[70:71], s[70:71], s[42:43]
    s_xor_b64 s[74:75], s[74:75], s[42:43]
    s_xor_b64 s[78:79], s[78:79], s[42:43]
    s_xor_b64 s[82:83], s[82:83], s[42:43]
    s_xor_b64 s[86:87], s[86:87], s[42:43]
    s_xor_b64 s[90:91], s[90:91], s[42:43]
    s_xor_b64 s[94:95], s[94:95], s[42:43]
    s_or_b64 s[66:67], s[66:67], s[70:71]
    s_or_b64 s[66:67], s[66:67], s[74:75]
    s_or_b64 s[66:67], s[66:67], s[78:79]
    s_or_b64 s[66:67], s[66:67], s[82:83]
    s_or_b64 s[66:67], s[66:67], s[86:87]
    s_or_b64 s[66:67], s[66:67], s[90:91]
    s_or_b64 s[66:67], s[66:67], s[94:95]
    s_cbranch_scc1 L_gO
    v_writelane_b32 v14, s64, 0
    v_writelane_b32 v14, s65, 1
    v_writelane_b32 v14, s68, 2
    v_writelane_b32 v14, s69, 3
    v_writelane_b32 v14, s72, 4
    v_writelane_b32 v14, s73, 5
    v_writelane_b32 v14, s76, 6
    v_writelane_b32 v14, s77, 7
    v_writelane_b32 v14, s80, 8
    v_writelane_b32 v14, s81, 9
    v_writelane_b32 v14, s84, 10
    v_writelane_b32 v14, s85, 11
    v_writelane_b32 v14, s88, 12
    v_writelane_b32 v14, s89, 13
    v_writelane_b32 v14, s92, 14
    v_writelane_b32 v14, s93, 15
    s_mov_b64 exec, 0xffff
    ds_write_b32 v141, v14
    s_mov_b64 exec, -1
    s_waitcnt lgkmcnt(0)
    s_barrier
    ds_read_b128 v[32:35], v10 offset:0
    ds_read_b128 v[36:39], v10 offset:64
    ds_read_b128 v[40:43], v10 offset:128
    ds_read_b128 v[44:47], v10 offset:192
    ds_read_b64_tr_b16 v[90:91], v8 offset:57344
    ds_read_b64_tr_b16 v[94:95], v9 offset:57344
    s_waitcnt lgkmcnt(5)
    v_mfma_f32_16x16x32_bf16 v[24:27], v[64:67], v[32:35], 0
    v_mfma_f32_16x16x32_bf16 v[52:55], v[68:71], v[32:35], 0
    s_waitcnt lgkmcnt(4)
    v_mfma_f32_16x16x32_bf16 v[24:27], v[72:75], v[36:39], v[24:27]
    v_mfma_f32_16x16x32_bf16 v[52:55], v[76:79], v[36:39], v[52:55]
    s_waitcnt lgkmcnt(3)
    v_mfma_f32_16x16x32_bf16 v[24:27], v[80:83], v[40:43], v[24:27]
    v_mfma_f32_16x16x32_bf16 v[52:55], v[84:87], v[40:43], v[52:55]
    s_waitcnt lgkmcnt(0)
    v_mfma_f32_16x16x32_bf16 v[24:27], v[88:91], v[44:47], v[24:27]
    v_mfma_f32_16x16x32_bf16 v[52:55], v[92:95], v[44:47], v[52:55]
    s_mov_b64 exec, s[20:21]
    s_cmp_lg_u64 s[60:61], 0
    s_nop 5
    v_cndmask_b32 v24, v24, v52, s[22:23]
    v_cndmask_b32 v25, v25, v53, s[22:23]
    v_cndmask_b32 v26, v26, v54, s[22:23]
    v_cndmask_b32 v27, v27, v55, s[22:23]
    v_and_or_b32 v24, v24, -2, v132
    s_cbranch_scc1 L_c_g
    global_store_dwordx4 v131, v[24:27], s[12:13]
    s_branch L_c_d
L_c_g:
    global_store_dwordx4 v131, v[24:27], s[12:13] sc1
L_c_d:
    s_cmp_gt_u32 s44, 0
    s_cbranch_scc1 L_end
    s_mov_b64 exec, -1
    s_mov_b32 s53, 0x200000
L_gC:
    global_load_dwordx4 v[32:35], v137, s[12:13] sc1
    global_load_dwordx4 v[36:39], v137, s[12:13] offset:1024 sc1
    s_sub_u32 s53, s53, 1
    s_cbranch_scc1 L_end
    s_waitcnt vmcnt(1)
    v_xor_b32 v40, v32, v138
    s_waitcnt vmcnt(0)
    v_xor_b32 v41, v36, v139
    v_or_b32 v40, v40, v41
    v_and_b32 v40, 1, v40
    v_cmp_ne_u32 vcc, 0, v40
    s_mov_b64 exec, vcc
    s_cbranch_execnz L_gC
    s_mov_b64 exec, -1
    v_and_b32 v32, -2, v32
    v_and_b32 v36, -2, v36
    v_pk_add_f32 v[34:35], v[34:35], v[38:39]
    v_pk_add_f32 v[32:33], v[32:33], v[36:37]
    s_and_b32 s47, s37, 127
    v_permlane32_swap_b32 v34, v35
    v_permlane32_swap_b32 v32, v33
    v_add_f32 v34, v34, v35
    v_add_f32 v32, v32, v33
    s_nop 1
    v_permlane16_swap_b32 v32, v34
    v_add_f32 v32, v32, v34
    s_nop 1
    v_add_f32_dpp v32, v32, v32 row_ror:8 row_mask:0xf bank_mask:0xf
    s_nop 1
    v_add_f32_dpp v32, v32, v32 row_ror:4 row_mask:0xf bank_mask:0xf
    s_mov_b64 exec, s[20:21]
    v_cvt_pk_bf16_f32 v32, v32, v32
    global_store_short v19, v32, s[40:41]
    s_cmp_lg_u32 s47, 0
    s_cbranch_scc1 L_noep
    s_mov_b64 exec, 1
    v_mov_b32 v24, s45
    global_store_dwordx2 v24, v[30:31], s[12:13]
L_noep:
L_end:
    s_endpgm
    .section .rodata,"a"
    .p2align 6
    .amdhsa_kernel concat_heads__sliding_block_cached__sliding_block_cached__decode_kernel
    .amdhsa_next_free_vgpr 152
    .amdhsa_next_free_sgpr 102
    .amdhsa_accum_offset 152
    .amdhsa_group_segment_fixed_size 0
    .amdhsa_kernarg_size 104
    .amdhsa_user_sgpr_count 2
    .amdhsa_user_sgpr_kernarg_segment_ptr 1
    .amdhsa_system_sgpr_workgroup_id_x 1
    .amdhsa_float_denorm_mode_32 3
    .end_amdhsa_kernel
```
